```python
import torch

def _softmax(x, axis=-1):
    return torch.softmax(x, dim=axis)
def _gelu(x):
    return torch.nn.functional.gelu(x, approximate="tanh")
def _silu(x):
    return torch.nn.functional.silu(x)
def _sigmoid(x):
    return torch.sigmoid(x)
def _layernorm(x, axis=-1, eps=1e-5):
    m = x.mean(dim=axis, keepdim=True)
    v = x.var(dim=axis, keepdim=True, unbiased=False)
    return (x - m) / torch.sqrt(v + eps)
def _scatter_add(tgt, idx, src, axis=0):
    return tgt.clone().index_add_(axis, idx, src)
def _segment_sum(src, seg, n):
    out = torch.zeros((n,) + src.shape[1:], dtype=src.dtype)
    return out.index_add_(0, seg, src)
def _pad(x, pw):
    flat = tuple(v for pair in reversed(pw) for v in pair)
    return torch.nn.functional.pad(x, flat)

kernel_name = 'standalone__low_rank_proj_linformer__sampling'

def setup_inputs():

    _w = (lambda a: (lambda t: t.to(torch.bfloat16) if t.is_floating_point() else t)(torch.as_tensor(a)))
    B, H, Sq, Skv, Dh, R = 16, 32, 32, 4096, 128, 16
    return {
        "q": _w((lambda *s: torch.randn(*s, dtype=torch.bfloat16) * 0.8)(B, H, Sq, Dh)),
        "k": _w((lambda *s: torch.randn(*s, dtype=torch.bfloat16) * 0.8)(B, H, Skv, Dh)),
        "v": _w((lambda *s: torch.randn(*s, dtype=torch.bfloat16) * 0.05)(B, H, Skv, Dh)),
        "e_proj": _w((lambda *s: torch.randn(*s, dtype=torch.bfloat16) * 0.8)(R, Skv) * (Skv ** -0.5)),
        "f_proj": _w((lambda *s: torch.randn(*s, dtype=torch.bfloat16) * 0.05)(R, Skv) * (Skv ** -0.5)),
    }

def reference(q, k, v, e_proj, f_proj):
    B, H, Sq, Dh = q.shape
    kp = torch.einsum("rn,bhnd->bhrd", e_proj, k)
    vp = torch.einsum("rn,bhnd->bhrd", f_proj, v)
    scores = torch.einsum("bhqd,bhrd->bhqr", q, kp) * (Dh ** -0.5)
    p = _softmax(scores, axis=-1)
    o = torch.einsum("bhqr,bhrd->bhqd", p, vp)
    return o
```

```asm
; @launch grid=(256,1,1) block=(128,1,1) lds=105744
.amdgcn_target "amdgcn-amd-amdhsa--gfx950"
.text
.globl standalone__low_rank_proj_linformer__sampling_kernel
.p2align 8
.type standalone__low_rank_proj_linformer__sampling_kernel,@function
standalone__low_rank_proj_linformer__sampling_kernel:
    s_cmp_ge_u32 s2, 256
    s_cbranch_scc1 L_end
    s_load_dwordx8 s[4:11], s[0:1], 0
    s_load_dwordx8 s[12:19], s[0:1], 32
    v_readfirstlane_b32 s3, v0
    v_and_b32 v4, 63, v0
    v_lshlrev_b32 v2, 4, v4
    v_and_b32 v5, 15, v0
    v_bfe_u32 v6, v0, 4, 2
    v_add_u32 v1, 0x1000, v2
    s_cmp_eq_u32 s3, 0
    s_cbranch_scc1 L_nocpf
    s_getpc_b64 s[56:57]
L_pc:
    v_lshlrev_b32 v232, 7, v4
    v_min_u32 v232, L_code_end-L_pc-4, v232
    global_load_dword v233, v232, s[56:57]
L_nocpf:
    s_lshr_b32 s53, s2, 11
    s_lshl_b32 s52, s2, 21
    s_mov_b32 s22, 0x200000
    s_mov_b32 s23, 0x00020000
    s_mov_b32 s26, 0x20000
    s_mov_b32 s27, 0x00020000
    s_mov_b32 s36, 0
    s_waitcnt lgkmcnt(0)
    s_add_u32 s20, s6, s52
    s_addc_u32 s21, s7, s53
    s_mov_b32 s24, s10
    s_mov_b32 s25, s11
    s_cmp_eq_u32 s3, 0
    s_cbranch_scc1 L_stream
    s_mov_b32 m0, 0
    s_mov_b32 s50, 0
L_hpre:
    buffer_load_dwordx4 v2, s[24:27], s50 offen lds
    s_add_u32 m0, m0, 1040
    s_add_u32 s50, s50, 0x2000
    s_cmp_lt_u32 s50, 0x20000
    s_cbranch_scc1 L_hpre
    s_branch L_helper
L_stream:
    buffer_load_dwordx4 v[112:115], v2, s[20:23], s36 offen offset:0 nt
    buffer_load_dwordx4 v[116:119], v2, s[20:23], s36 offen offset:1024 nt
    buffer_load_dwordx4 v[120:123], v2, s[20:23], s36 offen offset:2048 nt
    buffer_load_dwordx4 v[124:127], v2, s[20:23], s36 offen offset:3072 nt
    buffer_load_dwordx4 v[128:131], v1, s[20:23], s36 offen offset:0 nt
    buffer_load_dwordx4 v[132:135], v1, s[20:23], s36 offen offset:1024 nt
    s_mov_b32 m0, 16640
    s_mov_b32 s50, 1024
    buffer_load_dwordx4 v2, s[24:27], s50 offen lds
    buffer_load_dwordx4 v[136:139], v1, s[20:23], s36 offen offset:2048 nt
    buffer_load_dwordx4 v[140:143], v1, s[20:23], s36 offen offset:3072 nt
    s_add_u32 s36, s36, 0x2000
    buffer_load_dwordx4 v[144:147], v2, s[20:23], s36 offen offset:0 nt
    buffer_load_dwordx4 v[148:151], v2, s[20:23], s36 offen offset:1024 nt
    buffer_load_dwordx4 v[152:155], v2, s[20:23], s36 offen offset:2048 nt
    buffer_load_dwordx4 v[156:159], v2, s[20:23], s36 offen offset:3072 nt
    buffer_load_dwordx4 v[160:163], v1, s[20:23], s36 offen offset:0 nt
    buffer_load_dwordx4 v[164:167], v1, s[20:23], s36 offen offset:1024 nt
    s_mov_b32 m0, 17680
    s_mov_b32 s50, 9216
    buffer_load_dwordx4 v2, s[24:27], s50 offen lds
    buffer_load_dwordx4 v[168:171], v1, s[20:23], s36 offen offset:2048 nt
    buffer_load_dwordx4 v[172:175], v1, s[20:23], s36 offen offset:3072 nt
    s_add_u32 s36, s36, 0x2000
    buffer_load_dwordx4 v[176:179], v2, s[20:23], s36 offen offset:0 nt
    buffer_load_dwordx4 v[180:183], v2, s[20:23], s36 offen offset:1024 nt
    buffer_load_dwordx4 v[184:187], v2, s[20:23], s36 offen offset:2048 nt
    buffer_load_dwordx4 v[188:191], v2, s[20:23], s36 offen offset:3072 nt
    buffer_load_dwordx4 v[192:195], v1, s[20:23], s36 offen offset:0 nt
    buffer_load_dwordx4 v[196:199], v1, s[20:23], s36 offen offset:1024 nt
    s_mov_b32 m0, 18720
    s_mov_b32 s50, 17408
    buffer_load_dwordx4 v2, s[24:27], s50 offen lds
    buffer_load_dwordx4 v[200:203], v1, s[20:23], s36 offen offset:2048 nt
    buffer_load_dwordx4 v[204:207], v1, s[20:23], s36 offen offset:3072 nt
    s_add_u32 s36, s36, 0x2000
    buffer_load_dwordx4 v[208:211], v2, s[20:23], s36 offen offset:0 nt
    buffer_load_dwordx4 v[212:215], v2, s[20:23], s36 offen offset:1024 nt
    buffer_load_dwordx4 v[216:219], v2, s[20:23], s36 offen offset:2048 nt
    buffer_load_dwordx4 v[220:223], v2, s[20:23], s36 offen offset:3072 nt
    s_lshl_b32 s51, s2, 14
    s_add_u32 s32, s14, s51
    s_addc_u32 s33, s15, 0
    s_mov_b32 s34, 0x4000
    s_mov_b32 s35, 0x00020000
    v_lshlrev_b32 v7, 8, v5
    v_lshl_add_u32 v7, v6, 6, v7
    v_add_u32 v3, 66560, v2
    v_lshlrev_b32 v4, 3, v4
    v_add_u32 v4, 95488, v4
    v_mov_b32 v255, 105728
    v_lshlrev_b32 v245, 10, v6
    v_lshl_add_u32 v245, v5, 4, v245
    s_mov_b32 s37, 19
    s_add_u32 s44, s8, s52
    s_addc_u32 s45, s9, s53
    s_mov_b32 s41, 0x200000
    s_mov_b32 s39, 0x05040100
    s_mov_b32 s40, 0x07060302
    v_mul_u32_u24 v5, 1040, v5
    v_and_b32 v254, 1, v6
    v_mul_u32_u24 v254, 0x0202, v254
    v_lshl_add_u32 v254, v254, 16, v254
    v_add_u32 v254, s39, v254
    v_lshrrev_b32 v6, 1, v6
    v_lshl_add_u32 v5, v6, 2, v5
    s_mov_b32 s42, 0x2000
    s_mov_b32 s38, 0
    s_mov_b32 s59, 72
    s_mul_i32 s54, s2, 37
    s_bfe_u32 s54, s54, 0x70001
    s_mov_b64 vcc, 0
    s_and_b32 s50, s37, 15
    s_lshl_b32 s50, s50, 13
    s_bfe_u32 s51, s37, 0x30004
    s_lshl_b32 s51, s51, 10
    s_or_b32 s50, s50, s51
    s_and_b32 s51, s37, 63
    s_mul_i32 m0, s51, 1040
    s_cmp_eq_u32 s37, 256
    s_cselect_b32 s24, s12, s24
    s_cselect_b32 s25, s13, s25
    s_add_u32 s37, s37, 1
L_loop:
    s_bfe_u32 s52, s38, 0x20002
    s_mul_i32 s52, s52, 16640
    s_and_b32 s53, s38, 3
    s_lshl_b32 s53, s53, 8
    s_add_u32 s52, s52, s53
    v_add_u32 v6, s52, v5
    s_waitcnt vmcnt(26)
    s_cbranch_vccnz L_w0
    s_waitcnt vmcnt(19)
L_w0:
    buffer_load_dwordx4 v[224:227], v1, s[20:23], s36 offen offset:0 nt
    buffer_load_dwordx4 v[228:231], v1, s[20:23], s36 offen offset:1024 nt
    buffer_load_dwordx4 v2, s[24:27], s50 offen lds
    v_perm_b32 v40, v116, v112, s39
    v_perm_b32 v44, v116, v112, s40
    v_mfma_f32_16x16x32_bf16 v[8:11], v[108:111], v[72:75], v[8:11]
    v_perm_b32 v48, v117, v113, s39
    v_perm_b32 v52, v117, v113, s40
    v_perm_b32 v56, v118, v114, s39
    v_perm_b32 v60, v118, v114, s40
    v_mfma_f32_16x16x32_bf16 v[12:15], v[108:111], v[76:79], v[12:15]
    v_perm_b32 v64, v119, v115, s39
    v_perm_b32 v68, v119, v115, s40
    s_waitcnt vmcnt(26)
    s_cbranch_vccnz L_w1
    s_waitcnt vmcnt(20)
L_w1:
    buffer_load_dwordx4 v[232:235], v1, s[20:23], s36 offen offset:2048 nt
    buffer_load_dwordx4 v[236:239], v1, s[20:23], s36 offen offset:3072 nt
    s_add_u32 s36, s36, 0x2000
    s_cmp_eq_u32 s36, s41
    s_cselect_b32 s20, s44, s20
    s_cselect_b32 s21, s45, s21
    s_cselect_b32 s36, 0, s36
    s_cselect_b32 s41, -1, s41
    v_perm_b32 v41, v124, v120, s39
    v_perm_b32 v45, v124, v120, s40
    v_mfma_f32_16x16x32_bf16 v[16:19], v[108:111], v[80:83], v[16:19]
    v_perm_b32 v49, v125, v121, s39
    v_perm_b32 v53, v125, v121, s40
    v_perm_b32 v57, v126, v122, s39
    v_perm_b32 v61, v126, v122, s40
    v_mfma_f32_16x16x32_bf16 v[20:23], v[108:111], v[84:87], v[20:23]
    v_perm_b32 v65, v127, v123, s39
    v_perm_b32 v69, v127, v123, s40
    s_and_b32 s50, s37, 15
    s_lshl_b32 s50, s50, 13
    s_bfe_u32 s51, s37, 0x30004
    s_lshl_b32 s51, s51, 10
    s_or_b32 s50, s50, s51
    s_and_b32 s51, s37, 63
    s_mul_i32 m0, s51, 1040
    s_cmp_eq_u32 s37, 256
    s_cselect_b32 s24, s12, s24
    s_cselect_b32 s25, s13, s25
    s_add_u32 s37, s37, 1
    s_waitcnt vmcnt(26)
    s_cbranch_vccnz L_w2
    s_waitcnt vmcnt(19)
L_w2:
    buffer_load_dwordx4 v[112:115], v2, s[20:23], s36 offen offset:0 nt
    buffer_load_dwordx4 v[116:119], v2, s[20:23], s36 offen offset:1024 nt
    ds_read2_b32 v[246:247], v6 offset0:0 offset1:2
    ds_read2_b32 v[248:249], v6 offset0:4 offset1:6
    ds_read2_b32 v[250:251], v6 offset0:8 offset1:10
    ds_read2_b32 v[252:253], v6 offset0:12 offset1:14
    v_perm_b32 v42, v132, v128, s39
    v_perm_b32 v46, v132, v128, s40
    v_mfma_f32_16x16x32_bf16 v[24:27], v[108:111], v[88:91], v[24:27]
    v_perm_b32 v50, v133, v129, s39
    v_perm_b32 v54, v133, v129, s40
    v_perm_b32 v58, v134, v130, s39
    v_perm_b32 v62, v134, v130, s40
    v_mfma_f32_16x16x32_bf16 v[28:31], v[108:111], v[92:95], v[28:31]
    v_perm_b32 v66, v135, v131, s39
    v_perm_b32 v70, v135, v131, s40
    s_waitcnt vmcnt(26)
    s_cbranch_vccnz L_w3
    s_waitcnt vmcnt(19)
L_w3:
    buffer_load_dwordx4 v[120:123], v2, s[20:23], s36 offen offset:2048 nt
    buffer_load_dwordx4 v[124:127], v2, s[20:23], s36 offen offset:3072 nt
    v_perm_b32 v43, v140, v136, s39
    v_perm_b32 v47, v140, v136, s40
    v_mfma_f32_16x16x32_bf16 v[32:35], v[108:111], v[96:99], v[32:35]
    v_perm_b32 v51, v141, v137, s39
    v_perm_b32 v55, v141, v137, s40
    v_perm_b32 v59, v142, v138, s39
    v_perm_b32 v63, v142, v138, s40
    v_mfma_f32_16x16x32_bf16 v[36:39], v[108:111], v[100:103], v[36:39]
    v_perm_b32 v67, v143, v139, s39
    v_perm_b32 v71, v143, v139, s40
    s_waitcnt lgkmcnt(0)
    v_perm_b32 v104, v247, v246, v254
    v_perm_b32 v105, v249, v248, v254
    v_perm_b32 v106, v251, v250, v254
    v_perm_b32 v107, v253, v252, v254
    s_and_b32 s52, s38, 3
    s_cbranch_scc0 L_check
L_back:
    s_waitcnt vmcnt(26)
    s_cbranch_vccnz L_w4
    s_waitcnt vmcnt(19)
L_w4:
    buffer_load_dwordx4 v[128:131], v1, s[20:23], s36 offen offset:0 nt
    buffer_load_dwordx4 v[132:135], v1, s[20:23], s36 offen offset:1024 nt
    buffer_load_dwordx4 v2, s[24:27], s50 offen lds
    v_perm_b32 v72, v148, v144, s39
    v_perm_b32 v76, v148, v144, s40
    v_mfma_f32_16x16x32_bf16 v[8:11], v[104:107], v[40:43], v[8:11]
    v_perm_b32 v80, v149, v145, s39
    v_perm_b32 v84, v149, v145, s40
    v_perm_b32 v88, v150, v146, s39
    v_perm_b32 v92, v150, v146, s40
    v_mfma_f32_16x16x32_bf16 v[12:15], v[104:107], v[44:47], v[12:15]
    v_perm_b32 v96, v151, v147, s39
    v_perm_b32 v100, v151, v147, s40
    s_waitcnt vmcnt(26)
    s_cbranch_vccnz L_w5
    s_waitcnt vmcnt(20)
L_w5:
    buffer_load_dwordx4 v[136:139], v1, s[20:23], s36 offen offset:2048 nt
    buffer_load_dwordx4 v[140:143], v1, s[20:23], s36 offen offset:3072 nt
    s_add_u32 s36, s36, 0x2000
    v_perm_b32 v73, v156, v152, s39
    v_perm_b32 v77, v156, v152, s40
    v_mfma_f32_16x16x32_bf16 v[16:19], v[104:107], v[48:51], v[16:19]
    v_perm_b32 v81, v157, v153, s39
    v_perm_b32 v85, v157, v153, s40
    v_perm_b32 v89, v158, v154, s39
    v_perm_b32 v93, v158, v154, s40
    v_mfma_f32_16x16x32_bf16 v[20:23], v[104:107], v[52:55], v[20:23]
    v_perm_b32 v97, v159, v155, s39
    v_perm_b32 v101, v159, v155, s40
    s_and_b32 s50, s37, 15
    s_lshl_b32 s50, s50, 13
    s_bfe_u32 s51, s37, 0x30004
    s_lshl_b32 s51, s51, 10
    s_or_b32 s50, s50, s51
    s_and_b32 s51, s37, 63
    s_mul_i32 m0, s51, 1040
    s_cmp_eq_u32 s37, 256
    s_cselect_b32 s24, s12, s24
    s_cselect_b32 s25, s13, s25
    s_add_u32 s37, s37, 1
    s_waitcnt vmcnt(26)
    s_cbranch_vccnz L_w6
    s_waitcnt vmcnt(19)
L_w6:
    buffer_load_dwordx4 v[144:147], v2, s[20:23], s36 offen offset:0 nt
    buffer_load_dwordx4 v[148:151], v2, s[20:23], s36 offen offset:1024 nt
    ds_read2_b32 v[246:247], v6 offset0:16 offset1:18
    ds_read2_b32 v[248:249], v6 offset0:20 offset1:22
    ds_read2_b32 v[250:251], v6 offset0:24 offset1:26
    ds_read2_b32 v[252:253], v6 offset0:28 offset1:30
    v_perm_b32 v74, v164, v160, s39
    v_perm_b32 v78, v164, v160, s40
    v_mfma_f32_16x16x32_bf16 v[24:27], v[104:107], v[56:59], v[24:27]
    v_perm_b32 v82, v165, v161, s39
    v_perm_b32 v86, v165, v161, s40
    v_perm_b32 v90, v166, v162, s39
    v_perm_b32 v94, v166, v162, s40
    v_mfma_f32_16x16x32_bf16 v[28:31], v[104:107], v[60:63], v[28:31]
    v_perm_b32 v98, v167, v163, s39
    v_perm_b32 v102, v167, v163, s40
    s_waitcnt vmcnt(26)
    s_cbranch_vccnz L_w7
    s_waitcnt vmcnt(19)
L_w7:
    buffer_load_dwordx4 v[152:155], v2, s[20:23], s36 offen offset:2048 nt
    buffer_load_dwordx4 v[156:159], v2, s[20:23], s36 offen offset:3072 nt
    v_perm_b32 v75, v172, v168, s39
    v_perm_b32 v79, v172, v168, s40
    v_mfma_f32_16x16x32_bf16 v[32:35], v[104:107], v[64:67], v[32:35]
    v_perm_b32 v83, v173, v169, s39
    v_perm_b32 v87, v173, v169, s40
    v_perm_b32 v91, v174, v170, s39
    v_perm_b32 v95, v174, v170, s40
    v_mfma_f32_16x16x32_bf16 v[36:39], v[104:107], v[68:71], v[36:39]
    v_perm_b32 v99, v175, v171, s39
    v_perm_b32 v103, v175, v171, s40
    s_waitcnt lgkmcnt(0)
    v_perm_b32 v108, v247, v246, v254
    v_perm_b32 v109, v249, v248, v254
    v_perm_b32 v110, v251, v250, v254
    v_perm_b32 v111, v253, v252, v254
    s_cmp_eq_u32 s38, 0
    s_cbranch_scc1 L_first
L_back1:
    s_waitcnt vmcnt(26)
    s_cbranch_vccnz L_w8
    s_waitcnt vmcnt(19)
L_w8:
    buffer_load_dwordx4 v[160:163], v1, s[20:23], s36 offen offset:0 nt
    buffer_load_dwordx4 v[164:167], v1, s[20:23], s36 offen offset:1024 nt
    buffer_load_dwordx4 v2, s[24:27], s50 offen lds
    v_perm_b32 v40, v180, v176, s39
    v_perm_b32 v44, v180, v176, s40
    v_mfma_f32_16x16x32_bf16 v[8:11], v[108:111], v[72:75], v[8:11]
    v_perm_b32 v48, v181, v177, s39
    v_perm_b32 v52, v181, v177, s40
    v_perm_b32 v56, v182, v178, s39
    v_perm_b32 v60, v182, v178, s40
    v_mfma_f32_16x16x32_bf16 v[12:15], v[108:111], v[76:79], v[12:15]
    v_perm_b32 v64, v183, v179, s39
    v_perm_b32 v68, v183, v179, s40
    s_waitcnt vmcnt(26)
    s_cbranch_vccnz L_w9
    s_waitcnt vmcnt(20)
L_w9:
    buffer_load_dwordx4 v[168:171], v1, s[20:23], s36 offen offset:2048 nt
    buffer_load_dwordx4 v[172:175], v1, s[20:23], s36 offen offset:3072 nt
    s_add_u32 s36, s36, 0x2000
    v_perm_b32 v41, v188, v184, s39
    v_perm_b32 v45, v188, v184, s40
    v_mfma_f32_16x16x32_bf16 v[16:19], v[108:111], v[80:83], v[16:19]
    v_perm_b32 v49, v189, v185, s39
    v_perm_b32 v53, v189, v185, s40
    v_perm_b32 v57, v190, v186, s39
    v_perm_b32 v61, v190, v186, s40
    v_mfma_f32_16x16x32_bf16 v[20:23], v[108:111], v[84:87], v[20:23]
    v_perm_b32 v65, v191, v187, s39
    v_perm_b32 v69, v191, v187, s40
    s_and_b32 s50, s37, 15
    s_lshl_b32 s50, s50, 13
    s_bfe_u32 s51, s37, 0x30004
    s_lshl_b32 s51, s51, 10
    s_or_b32 s50, s50, s51
    s_and_b32 s51, s37, 63
    s_mul_i32 m0, s51, 1040
    s_cmp_eq_u32 s37, 256
    s_cselect_b32 s24, s12, s24
    s_cselect_b32 s25, s13, s25
    s_add_u32 s37, s37, 1
    s_waitcnt vmcnt(26)
    s_cbranch_vccnz L_w10
    s_waitcnt vmcnt(19)
L_w10:
    buffer_load_dwordx4 v[176:179], v2, s[20:23], s36 offen offset:0 nt
    buffer_load_dwordx4 v[180:183], v2, s[20:23], s36 offen offset:1024 nt
    ds_read2_b32 v[246:247], v6 offset0:32 offset1:34
    ds_read2_b32 v[248:249], v6 offset0:36 offset1:38
    ds_read2_b32 v[250:251], v6 offset0:40 offset1:42
    ds_read2_b32 v[252:253], v6 offset0:44 offset1:46
    ds_read_b32 v244, v255
    v_perm_b32 v42, v196, v192, s39
    v_perm_b32 v46, v196, v192, s40
    v_mfma_f32_16x16x32_bf16 v[24:27], v[108:111], v[88:91], v[24:27]
    v_perm_b32 v50, v197, v193, s39
    v_perm_b32 v54, v197, v193, s40
    v_perm_b32 v58, v198, v194, s39
    v_perm_b32 v62, v198, v194, s40
    v_mfma_f32_16x16x32_bf16 v[28:31], v[108:111], v[92:95], v[28:31]
    v_perm_b32 v66, v199, v195, s39
    v_perm_b32 v70, v199, v195, s40
    s_waitcnt vmcnt(26)
    s_cbranch_vccnz L_w11
    s_waitcnt vmcnt(19)
L_w11:
    buffer_load_dwordx4 v[184:187], v2, s[20:23], s36 offen offset:2048 nt
    buffer_load_dwordx4 v[188:191], v2, s[20:23], s36 offen offset:3072 nt
    v_perm_b32 v43, v204, v200, s39
    v_perm_b32 v47, v204, v200, s40
    v_mfma_f32_16x16x32_bf16 v[32:35], v[108:111], v[96:99], v[32:35]
    v_perm_b32 v51, v205, v201, s39
    v_perm_b32 v55, v205, v201, s40
    v_perm_b32 v59, v206, v202, s39
    v_perm_b32 v63, v206, v202, s40
    v_mfma_f32_16x16x32_bf16 v[36:39], v[108:111], v[100:103], v[36:39]
    v_perm_b32 v67, v207, v203, s39
    v_perm_b32 v71, v207, v203, s40
    s_waitcnt lgkmcnt(0)
    v_perm_b32 v104, v247, v246, v254
    v_perm_b32 v105, v249, v248, v254
    v_perm_b32 v106, v251, v250, v254
    v_perm_b32 v107, v253, v252, v254
    s_waitcnt vmcnt(26)
    s_cbranch_vccnz L_w12
    s_waitcnt vmcnt(19)
L_w12:
    buffer_load_dwordx4 v[192:195], v1, s[20:23], s36 offen offset:0 nt
    buffer_load_dwordx4 v[196:199], v1, s[20:23], s36 offen offset:1024 nt
    buffer_load_dwordx4 v2, s[24:27], s50 offen lds
    v_perm_b32 v72, v212, v208, s39
    v_perm_b32 v76, v212, v208, s40
    v_mfma_f32_16x16x32_bf16 v[8:11], v[104:107], v[40:43], v[8:11]
    v_perm_b32 v80, v213, v209, s39
    v_perm_b32 v84, v213, v209, s40
    v_perm_b32 v88, v214, v210, s39
    v_perm_b32 v92, v214, v210, s40
    v_mfma_f32_16x16x32_bf16 v[12:15], v[104:107], v[44:47], v[12:15]
    v_perm_b32 v96, v215, v211, s39
    v_perm_b32 v100, v215, v211, s40
    v_readfirstlane_b32 s59, v244
    s_waitcnt vmcnt(26)
    s_cbranch_vccnz L_w13
    s_waitcnt vmcnt(20)
L_w13:
    buffer_load_dwordx4 v[200:203], v1, s[20:23], s36 offen offset:2048 nt
    buffer_load_dwordx4 v[204:207], v1, s[20:23], s36 offen offset:3072 nt
    s_add_u32 s36, s36, 0x2000
    v_perm_b32 v73, v220, v216, s39
    v_perm_b32 v77, v220, v216, s40
    v_mfma_f32_16x16x32_bf16 v[16:19], v[104:107], v[48:51], v[16:19]
    v_perm_b32 v81, v221, v217, s39
    v_perm_b32 v85, v221, v217, s40
    v_perm_b32 v89, v222, v218, s39
    v_perm_b32 v93, v222, v218, s40
    v_mfma_f32_16x16x32_bf16 v[20:23], v[104:107], v[52:55], v[20:23]
    v_perm_b32 v97, v223, v219, s39
    v_perm_b32 v101, v223, v219, s40
    s_and_b32 s50, s37, 15
    s_lshl_b32 s50, s50, 13
    s_bfe_u32 s51, s37, 0x30004
    s_lshl_b32 s51, s51, 10
    s_or_b32 s50, s50, s51
    s_and_b32 s51, s37, 63
    s_mul_i32 m0, s51, 1040
    s_cmp_eq_u32 s37, 256
    s_cselect_b32 s24, s12, s24
    s_cselect_b32 s25, s13, s25
    s_add_u32 s37, s37, 1
    s_waitcnt vmcnt(26)
    s_cbranch_vccnz L_w14
    s_waitcnt vmcnt(19)
L_w14:
    buffer_load_dwordx4 v[208:211], v2, s[20:23], s36 offen offset:0 nt
    buffer_load_dwordx4 v[212:215], v2, s[20:23], s36 offen offset:1024 nt
    ds_read2_b32 v[246:247], v6 offset0:48 offset1:50
    ds_read2_b32 v[248:249], v6 offset0:52 offset1:54
    ds_read2_b32 v[250:251], v6 offset0:56 offset1:58
    ds_read2_b32 v[252:253], v6 offset0:60 offset1:62
    v_perm_b32 v74, v228, v224, s39
    v_perm_b32 v78, v228, v224, s40
    v_mfma_f32_16x16x32_bf16 v[24:27], v[104:107], v[56:59], v[24:27]
    v_perm_b32 v82, v229, v225, s39
    v_perm_b32 v86, v229, v225, s40
    v_perm_b32 v90, v230, v226, s39
    v_perm_b32 v94, v230, v226, s40
    v_mfma_f32_16x16x32_bf16 v[28:31], v[104:107], v[60:63], v[28:31]
    v_perm_b32 v98, v231, v227, s39
    v_perm_b32 v102, v231, v227, s40
    s_waitcnt vmcnt(26)
    s_cbranch_vccnz L_w15
    s_waitcnt vmcnt(19)
L_w15:
    buffer_load_dwordx4 v[216:219], v2, s[20:23], s36 offen offset:2048 nt
    buffer_load_dwordx4 v[220:223], v2, s[20:23], s36 offen offset:3072 nt
    v_perm_b32 v75, v236, v232, s39
    v_perm_b32 v79, v236, v232, s40
    v_mfma_f32_16x16x32_bf16 v[32:35], v[104:107], v[64:67], v[32:35]
    v_perm_b32 v83, v237, v233, s39
    v_perm_b32 v87, v237, v233, s40
    v_perm_b32 v91, v238, v234, s39
    v_perm_b32 v95, v238, v234, s40
    v_mfma_f32_16x16x32_bf16 v[36:39], v[104:107], v[68:71], v[36:39]
    v_perm_b32 v99, v239, v235, s39
    v_perm_b32 v103, v239, v235, s40
    s_waitcnt lgkmcnt(0)
    v_perm_b32 v108, v247, v246, v254
    v_perm_b32 v109, v249, v248, v254
    v_perm_b32 v110, v251, v250, v254
    v_perm_b32 v111, v253, v252, v254
    s_add_u32 s38, s38, 1
    s_add_u32 s54, s54, s59
    s_bitcmp1_b32 s54, 7
    s_cselect_b64 vcc, -1, 0
    s_and_b32 s54, s54, 127
    s_cmp_ge_u32 s38, 127
    s_cselect_b64 vcc, -1, vcc
    s_cmp_lt_u32 s38, 128
    s_cbranch_scc1 L_loop
    v_mfma_f32_16x16x32_bf16 v[8:11], v[108:111], v[72:75], v[8:11]
    v_mfma_f32_16x16x32_bf16 v[12:15], v[108:111], v[76:79], v[12:15]
    v_mfma_f32_16x16x32_bf16 v[16:19], v[108:111], v[80:83], v[16:19]
    v_mfma_f32_16x16x32_bf16 v[20:23], v[108:111], v[84:87], v[20:23]
    v_mfma_f32_16x16x32_bf16 v[24:27], v[108:111], v[88:91], v[24:27]
    v_mfma_f32_16x16x32_bf16 v[28:31], v[108:111], v[92:95], v[28:31]
    v_mfma_f32_16x16x32_bf16 v[32:35], v[108:111], v[96:99], v[32:35]
    v_mfma_f32_16x16x32_bf16 v[36:39], v[108:111], v[100:103], v[36:39]
    s_waitcnt vmcnt(0)
L_vepi:
    s_add_u32 s43, s42, 0x1000
    v_cvt_pk_bf16_f32 v152, v8, v9
    v_cvt_pk_bf16_f32 v153, v10, v11
    v_cvt_pk_bf16_f32 v154, v12, v13
    v_cvt_pk_bf16_f32 v155, v14, v15
    v_mfma_f32_16x16x16_bf16 v[8:11], v[240:241], v[152:153], 0
    v_cvt_pk_bf16_f32 v156, v16, v17
    v_cvt_pk_bf16_f32 v157, v18, v19
    v_mfma_f32_16x16x16_bf16 v[12:15], v[240:241], v[154:155], 0
    v_cvt_pk_bf16_f32 v158, v20, v21
    v_cvt_pk_bf16_f32 v159, v22, v23
    v_mfma_f32_16x16x16_bf16 v[16:19], v[240:241], v[156:157], 0
    v_cvt_pk_bf16_f32 v160, v24, v25
    v_cvt_pk_bf16_f32 v161, v26, v27
    v_mfma_f32_16x16x16_bf16 v[20:23], v[240:241], v[158:159], 0
    v_cvt_pk_bf16_f32 v162, v28, v29
    v_cvt_pk_bf16_f32 v163, v30, v31
    v_mfma_f32_16x16x16_bf16 v[24:27], v[240:241], v[160:161], 0
    v_cvt_pk_bf16_f32 v164, v32, v33
    v_cvt_pk_bf16_f32 v165, v34, v35
    v_mfma_f32_16x16x16_bf16 v[28:31], v[240:241], v[162:163], 0
    v_cvt_pk_bf16_f32 v166, v36, v37
    v_cvt_pk_bf16_f32 v167, v38, v39
    v_mfma_f32_16x16x16_bf16 v[32:35], v[240:241], v[164:165], 0
    s_nop 1
    v_mfma_f32_16x16x16_bf16 v[36:39], v[240:241], v[166:167], 0
    v_mfma_f32_16x16x16_bf16 v[168:171], v[242:243], v[152:153], 0
    v_mfma_f32_16x16x16_bf16 v[172:175], v[242:243], v[154:155], 0
    v_mfma_f32_16x16x16_bf16 v[176:179], v[242:243], v[156:157], 0
    v_mfma_f32_16x16x16_bf16 v[180:183], v[242:243], v[158:159], 0
    v_mfma_f32_16x16x16_bf16 v[184:187], v[242:243], v[160:161], 0
    v_mfma_f32_16x16x16_bf16 v[188:191], v[242:243], v[162:163], 0
    v_mfma_f32_16x16x16_bf16 v[192:195], v[242:243], v[164:165], 0
    v_mfma_f32_16x16x16_bf16 v[196:199], v[242:243], v[166:167], 0
    v_cvt_pk_bf16_f32 v200, v8, v12
    v_cvt_pk_bf16_f32 v201, v16, v20
    v_cvt_pk_bf16_f32 v202, v24, v28
    v_cvt_pk_bf16_f32 v203, v32, v36
    buffer_store_dwordx4 v[200:203], v245, s[32:35], s42 offen offset:0
    v_cvt_pk_bf16_f32 v204, v9, v13
    v_cvt_pk_bf16_f32 v205, v17, v21
    v_cvt_pk_bf16_f32 v206, v25, v29
    v_cvt_pk_bf16_f32 v207, v33, v37
    buffer_store_dwordx4 v[204:207], v245, s[32:35], s42 offen offset:256
    v_cvt_pk_bf16_f32 v208, v10, v14
    v_cvt_pk_bf16_f32 v209, v18, v22
    v_cvt_pk_bf16_f32 v210, v26, v30
    v_cvt_pk_bf16_f32 v211, v34, v38
    buffer_store_dwordx4 v[208:211], v245, s[32:35], s42 offen offset:512
    v_cvt_pk_bf16_f32 v212, v11, v15
    v_cvt_pk_bf16_f32 v213, v19, v23
    v_cvt_pk_bf16_f32 v214, v27, v31
    v_cvt_pk_bf16_f32 v215, v35, v39
    buffer_store_dwordx4 v[212:215], v245, s[32:35], s42 offen offset:768
    v_cvt_pk_bf16_f32 v8, v168, v172
    v_cvt_pk_bf16_f32 v9, v176, v180
    v_cvt_pk_bf16_f32 v10, v184, v188
    v_cvt_pk_bf16_f32 v11, v192, v196
    buffer_store_dwordx4 v[8:11], v245, s[32:35], s43 offen offset:0
    v_cvt_pk_bf16_f32 v12, v169, v173
    v_cvt_pk_bf16_f32 v13, v177, v181
    v_cvt_pk_bf16_f32 v14, v185, v189
    v_cvt_pk_bf16_f32 v15, v193, v197
    buffer_store_dwordx4 v[12:15], v245, s[32:35], s43 offen offset:256
    v_cvt_pk_bf16_f32 v16, v170, v174
    v_cvt_pk_bf16_f32 v17, v178, v182
    v_cvt_pk_bf16_f32 v18, v186, v190
    v_cvt_pk_bf16_f32 v19, v194, v198
    buffer_store_dwordx4 v[16:19], v245, s[32:35], s43 offen offset:512
    v_cvt_pk_bf16_f32 v20, v171, v175
    v_cvt_pk_bf16_f32 v21, v179, v183
    v_cvt_pk_bf16_f32 v22, v187, v191
    v_cvt_pk_bf16_f32 v23, v195, v199
    buffer_store_dwordx4 v[20:23], v245, s[32:35], s43 offen offset:768
    s_cmp_lg_u32 s3, 0
    s_cbranch_scc1 L_hloop
L_end:
    s_endpgm
L_check:
    s_and_b32 s52, s38, 31
    s_cbranch_scc0 L_ph
    s_barrier
    s_branch L_back
L_ph:
    s_cmp_eq_u32 s38, 0
    s_nop 2
    s_cbranch_scc1 L_back
    ds_write_b128 v3, v[8:11] offset:0
    ds_write_b128 v3, v[12:15] offset:1024
    ds_write_b128 v3, v[16:19] offset:2048
    ds_write_b128 v3, v[20:23] offset:3072
    ds_write_b128 v3, v[24:27] offset:4096
    ds_write_b128 v3, v[28:31] offset:5120
    ds_write_b128 v3, v[32:35] offset:6144
    ds_write_b128 v3, v[36:39] offset:7168
    v_add_u32 v3, 0x2000, v3
    s_waitcnt lgkmcnt(0)
    s_barrier
    ds_read_b64 v[240:241], v4 offset:1024
    ds_read_b64 v[242:243], v4 offset:1536
L_zero:
    v_mov_b32 v8, 0
    v_mov_b32 v9, 0
    v_mov_b32 v10, 0
    v_mov_b32 v11, 0
    v_mov_b32 v12, 0
    v_mov_b32 v13, 0
    v_mov_b32 v14, 0
    v_mov_b32 v15, 0
    v_mov_b32 v16, 0
    v_mov_b32 v17, 0
    v_mov_b32 v18, 0
    v_mov_b32 v19, 0
    v_mov_b32 v20, 0
    v_mov_b32 v21, 0
    v_mov_b32 v22, 0
    v_mov_b32 v23, 0
    v_mov_b32 v24, 0
    v_mov_b32 v25, 0
    v_mov_b32 v26, 0
    v_mov_b32 v27, 0
    v_mov_b32 v28, 0
    v_mov_b32 v29, 0
    v_mov_b32 v30, 0
    v_mov_b32 v31, 0
    v_mov_b32 v32, 0
    v_mov_b32 v33, 0
    v_mov_b32 v34, 0
    v_mov_b32 v35, 0
    v_mov_b32 v36, 0
    v_mov_b32 v37, 0
    v_mov_b32 v38, 0
    v_mov_b32 v39, 0
    s_branch L_back
L_first:
    s_barrier
    ds_read2_b32 v[246:247], v6 offset0:0 offset1:2
    ds_read2_b32 v[248:249], v6 offset0:4 offset1:6
    ds_read2_b32 v[250:251], v6 offset0:8 offset1:10
    ds_read2_b32 v[252:253], v6 offset0:12 offset1:14
    s_waitcnt lgkmcnt(0)
    v_perm_b32 v104, v247, v246, v254
    v_perm_b32 v105, v249, v248, v254
    v_perm_b32 v106, v251, v250, v254
    v_perm_b32 v107, v253, v252, v254
    ds_read2_b32 v[246:247], v6 offset0:16 offset1:18
    ds_read2_b32 v[248:249], v6 offset0:20 offset1:22
    ds_read2_b32 v[250:251], v6 offset0:24 offset1:26
    ds_read2_b32 v[252:253], v6 offset0:28 offset1:30
    s_nop 0
    v_mfma_f32_16x16x32_bf16 v[8:11], v[104:107], v[40:43], 0
    v_mfma_f32_16x16x32_bf16 v[12:15], v[104:107], v[44:47], 0
    v_mfma_f32_16x16x32_bf16 v[16:19], v[104:107], v[48:51], 0
    v_mfma_f32_16x16x32_bf16 v[20:23], v[104:107], v[52:55], 0
    v_mfma_f32_16x16x32_bf16 v[24:27], v[104:107], v[56:59], 0
    v_mfma_f32_16x16x32_bf16 v[28:31], v[104:107], v[60:63], 0
    v_mfma_f32_16x16x32_bf16 v[32:35], v[104:107], v[64:67], 0
    v_mfma_f32_16x16x32_bf16 v[36:39], v[104:107], v[68:71], 0
    s_waitcnt lgkmcnt(0)
    v_perm_b32 v108, v247, v246, v254
    v_perm_b32 v109, v249, v248, v254
    v_perm_b32 v110, v251, v250, v254
    v_perm_b32 v111, v253, v252, v254
    s_branch L_back1
L_helper:
    s_lshr_b32 s58, s2, 3
    s_lshl_b32 s58, s58, 12
    s_lshl_b32 s51, s2, 14
    s_add_u32 s32, s14, s51
    s_addc_u32 s33, s15, 0
    s_mov_b32 s34, 0x4000
    s_mov_b32 s35, 0x00020000
    v_lshlrev_b32 v7, 8, v5
    v_lshl_add_u32 v7, v6, 6, v7
    v_add_u32 v3, 66560, v2
    v_lshlrev_b32 v4, 3, v4
    v_add_u32 v4, 95488, v4
    v_mov_b32 v255, 105728
    v_lshlrev_b32 v245, 10, v6
    v_lshl_add_u32 v245, v5, 4, v245
    v_mov_b32 v150, 72
    ds_write_b32 v255, v150
    s_add_u32 s28, s4, s51
    s_addc_u32 s29, s5, 0
    s_mov_b32 s30, 0x4000
    s_mov_b32 s31, 0x00020000
    v_mul_u32_u24 v1, 1088, v6
    v_lshl_add_u32 v1, v5, 4, v1
    v_add_u32 v1, 91136, v1
    v_mul_u32_u24 v145, 272, v5
    v_lshl_add_u32 v145, v6, 6, v145
    v_add_u32 v145, 91136, v145
    v_mov_b32 v144, v4
    v_add_u32 v146, 97536, v7
    s_mov_b32 s48, 0x3db504f3
    s_mov_b32 s49, 0x3fb8aa3b
    s_mov_b32 s42, 0
    s_mov_b32 s38, 0
    s_mov_b32 s60, 2
    s_mov_b32 s61, 0
    s_mov_b32 s55, 0
    v_mov_b32 v151, 72.0
    s_waitcnt vmcnt(0) lgkmcnt(0)
    s_barrier
    buffer_load_dwordx4 v[216:219], v2, s[24:27], s58 offen offset:0
    buffer_load_dwordx4 v[220:223], v2, s[24:27], s58 offen offset:1024
    buffer_load_dwordx4 v[224:227], v2, s[24:27], s58 offen offset:2048
    buffer_load_dwordx4 v[228:231], v2, s[24:27], s58 offen offset:3072
    s_mov_b32 s24, s12
    s_mov_b32 s25, s13
L_hloop:
    s_cmp_ge_u32 s38, 31
    s_cbranch_scc1 L_end
    s_barrier
    s_add_u32 s38, s38, 1
    s_cmp_lg_u32 s38, 6
    s_cbranch_scc1 L_nopf
    buffer_load_dwordx4 v[216:219], v2, s[24:27], s58 offen offset:0
    buffer_load_dwordx4 v[220:223], v2, s[24:27], s58 offen offset:1024
    buffer_load_dwordx4 v[224:227], v2, s[24:27], s58 offen offset:2048
    buffer_load_dwordx4 v[228:231], v2, s[24:27], s58 offen offset:3072
L_nopf:
    s_cmp_lg_u32 s38, s60
    s_cbranch_scc1 L_pa
    s_memrealtime s[56:57]
    s_waitcnt lgkmcnt(0)
    s_or_b32 s55, s56, 1
    s_cmp_ge_u32 s2, 2
    s_cbranch_scc1 L_pa
    s_lshl_b32 s52, s2, 2
    s_add_u32 s52, s52, s61
    v_mov_b32 v149, s55
    v_mov_b32 v147, s52
    s_mov_b64 exec, 1
    global_store_dword v147, v149, s[16:17] sc0 sc1
    s_mov_b64 exec, -1
L_pa:
    s_add_u32 s52, s60, 1
    s_cmp_lg_u32 s38, s52
    s_cbranch_scc1 L_pb
    v_lshrrev_b32 v147, 2, v2
    v_and_b32 v147, 7, v147
    v_add_u32 v147, s61, v147
    global_load_dword v149, v147, s[16:17] sc1
    s_add_u32 s60, s60, 2
    s_add_u32 s61, s61, 8
    s_cmp_ge_u32 s61, 120
    s_cselect_b32 s60, 0x1000, s60
    s_mov_b32 s52, 0
    s_mov_b32 s53, 0
    s_mov_b32 s54, 0
    s_waitcnt vmcnt(0)
L_pl:
    v_readlane_b32 s56, v149, s52
    s_add_u32 s52, s52, 1
    s_nop 0
    s_sub_u32 s57, s55, s56
    s_cmp_lg_u32 s56, 0
    s_cselect_b32 s57, s57, 0
    s_addc_u32 s54, s54, 0
    s_add_u32 s53, s53, s57
    s_cmp_lt_u32 s52, 2
    s_cbranch_scc1 L_pl
    s_max_u32 s54, s54, 1
    v_cvt_f32_i32 v147, s53
    v_cvt_f32_u32 v149, s54
    v_rcp_f32 v149, v149
    s_nop 0
    v_mul_f32 v147, v147, v149
    v_mul_f32 v149, 0.046875, v147
    v_add_f32 v151, v151, v149
    v_max_f32 v151, 0, v151
    v_min_f32 v151, 0x43000000, v151
    v_mul_f32 v147, 0.37109375, v147
    v_add_f32 v147, v147, v151
    v_cvt_i32_f32 v150, v147
    v_max_i32 v150, 0, v150
    v_min_i32 v150, 0x80, v150
    ds_write_b32 v255, v150
    s_waitcnt lgkmcnt(0)
L_pb:
    s_cmp_eq_u32 s38, 31
    s_cbranch_scc1 L_hv
    s_and_b32 s52, s38, 7
    s_cbranch_scc1 L_hloop
    s_cmp_ge_u32 s38, 24
    s_cbranch_scc1 L_hloop
    s_mov_b32 m0, 97536
    s_add_u32 s43, s42, 0x1000
    buffer_load_dwordx4 v2, s[28:31], s42 offen offset:0 nt lds
    buffer_load_dwordx4 v2, s[28:31], s42 offen offset:1024 nt lds
    buffer_load_dwordx4 v2, s[28:31], s42 offen offset:2048 nt lds
    buffer_load_dwordx4 v2, s[28:31], s42 offen offset:3072 nt lds
    s_mov_b32 m0, 101632
    s_nop 0
    buffer_load_dwordx4 v2, s[28:31], s43 offen offset:0 nt lds
    buffer_load_dwordx4 v2, s[28:31], s43 offen offset:1024 nt lds
    buffer_load_dwordx4 v2, s[28:31], s43 offen offset:2048 nt lds
    buffer_load_dwordx4 v2, s[28:31], s43 offen offset:3072 nt lds
    ds_read_b128 v[8:11], v3 offset:0
    ds_read_b128 v[12:15], v3 offset:1024
    ds_read_b128 v[16:19], v3 offset:2048
    ds_read_b128 v[20:23], v3 offset:3072
    ds_read_b128 v[24:27], v3 offset:4096
    ds_read_b128 v[28:31], v3 offset:5120
    ds_read_b128 v[32:35], v3 offset:6144
    ds_read_b128 v[36:39], v3 offset:7168
    v_add_u32 v3, 0x2000, v3
    s_waitcnt lgkmcnt(0)
    v_cvt_pk_bf16_f32 v104, v8, v12
    v_cvt_pk_bf16_f32 v105, v16, v20
    v_cvt_pk_bf16_f32 v106, v24, v28
    v_cvt_pk_bf16_f32 v107, v32, v36
    v_cvt_pk_bf16_f32 v108, v9, v13
    v_cvt_pk_bf16_f32 v109, v17, v21
    v_cvt_pk_bf16_f32 v110, v25, v29
    v_cvt_pk_bf16_f32 v111, v33, v37
    v_cvt_pk_bf16_f32 v112, v10, v14
    v_cvt_pk_bf16_f32 v113, v18, v22
    v_cvt_pk_bf16_f32 v114, v26, v30
    v_cvt_pk_bf16_f32 v115, v34, v38
    v_cvt_pk_bf16_f32 v116, v11, v15
    v_cvt_pk_bf16_f32 v117, v19, v23
    v_cvt_pk_bf16_f32 v118, v27, v31
    v_cvt_pk_bf16_f32 v119, v35, v39
    ds_write_b128 v1, v[104:107] offset:0
    ds_write_b128 v1, v[108:111] offset:272
    ds_write_b128 v1, v[112:115] offset:544
    ds_write_b128 v1, v[116:119] offset:816
    s_waitcnt vmcnt(0) lgkmcnt(0)
    ds_read_b128 v[120:123], v145 offset:0
    ds_read_b128 v[124:127], v145 offset:16
    ds_read_b128 v[128:131], v145 offset:32
    ds_read_b128 v[132:135], v145 offset:48
    ds_read_b128 v[72:75], v146 offset:0
    ds_read_b128 v[76:79], v146 offset:16
    ds_read_b128 v[80:83], v146 offset:32
    ds_read_b128 v[84:87], v146 offset:48
    ds_read_b128 v[88:91], v146 offset:4096
    ds_read_b128 v[92:95], v146 offset:4112
    ds_read_b128 v[96:99], v146 offset:4128
    ds_read_b128 v[100:103], v146 offset:4144
    s_waitcnt lgkmcnt(0)
    v_mfma_f32_16x16x32_bf16 v[136:139], v[120:123], v[72:75], 0
    v_mfma_f32_16x16x32_bf16 v[136:139], v[124:127], v[76:79], v[136:139]
    v_mfma_f32_16x16x32_bf16 v[136:139], v[128:131], v[80:83], v[136:139]
    v_mfma_f32_16x16x32_bf16 v[136:139], v[132:135], v[84:87], v[136:139]
    s_nop 7
    v_cvt_pk_bf16_f32 v140, v136, v137
    v_cvt_pk_bf16_f32 v141, v138, v139
    v_lshlrev_b32 v136, 16, v140
    v_and_b32 v137, 0xffff0000, v140
    v_lshlrev_b32 v138, 16, v141
    v_and_b32 v139, 0xffff0000, v141
    v_mul_f32 v136, s48, v136
    v_mul_f32 v137, s48, v137
    v_mul_f32 v138, s48, v138
    v_mul_f32 v139, s48, v139
    v_cvt_pk_bf16_f32 v140, v136, v137
    v_cvt_pk_bf16_f32 v141, v138, v139
    v_lshlrev_b32 v136, 16, v140
    v_and_b32 v137, 0xffff0000, v140
    v_lshlrev_b32 v138, 16, v141
    v_and_b32 v139, 0xffff0000, v141
    v_max_f32 v142, v136, v137
    v_max3_f32 v142, v142, v138, v139
    v_mov_b32 v143, v142
    s_nop 1
    v_permlane16_swap_b32 v142, v143
    s_nop 1
    v_max_f32 v142, v142, v143
    v_mov_b32 v143, v142
    s_nop 1
    v_permlane32_swap_b32 v142, v143
    s_nop 1
    v_max_f32 v142, v142, v143
    v_sub_f32 v136, v136, v142
    v_sub_f32 v137, v137, v142
    v_sub_f32 v138, v138, v142
    v_sub_f32 v139, v139, v142
    v_mul_f32 v136, s49, v136
    v_mul_f32 v137, s49, v137
    v_mul_f32 v138, s49, v138
    v_mul_f32 v139, s49, v139
    v_exp_f32 v136, v136
    v_exp_f32 v137, v137
    v_exp_f32 v138, v138
    v_exp_f32 v139, v139
    s_nop 0
    v_add_f32 v142, v136, v137
    v_add_f32 v143, v138, v139
    v_add_f32 v142, v142, v143
    v_mov_b32 v143, v142
    s_nop 1
    v_permlane16_swap_b32 v142, v143
    s_nop 1
    v_add_f32 v142, v142, v143
    v_mov_b32 v143, v142
    s_nop 1
    v_permlane32_swap_b32 v142, v143
    s_nop 1
    v_add_f32 v142, v142, v143
    v_rcp_f32 v142, v142
    s_nop 0
    v_mul_f32 v136, v136, v142
    v_mul_f32 v137, v137, v142
    v_mul_f32 v138, v138, v142
    v_mul_f32 v139, v139, v142
    v_cvt_pk_bf16_f32 v140, v136, v137
    v_cvt_pk_bf16_f32 v141, v138, v139
    ds_write_b64 v144, v[140:141] offset:0
    s_waitcnt lgkmcnt(0)
    v_mfma_f32_16x16x32_bf16 v[136:139], v[120:123], v[88:91], 0
    v_mfma_f32_16x16x32_bf16 v[136:139], v[124:127], v[92:95], v[136:139]
    v_mfma_f32_16x16x32_bf16 v[136:139], v[128:131], v[96:99], v[136:139]
    v_mfma_f32_16x16x32_bf16 v[136:139], v[132:135], v[100:103], v[136:139]
    s_nop 7
    v_cvt_pk_bf16_f32 v140, v136, v137
    v_cvt_pk_bf16_f32 v141, v138, v139
    v_lshlrev_b32 v136, 16, v140
    v_and_b32 v137, 0xffff0000, v140
    v_lshlrev_b32 v138, 16, v141
    v_and_b32 v139, 0xffff0000, v141
    v_mul_f32 v136, s48, v136
    v_mul_f32 v137, s48, v137
    v_mul_f32 v138, s48, v138
    v_mul_f32 v139, s48, v139
    v_cvt_pk_bf16_f32 v140, v136, v137
    v_cvt_pk_bf16_f32 v141, v138, v139
    v_lshlrev_b32 v136, 16, v140
    v_and_b32 v137, 0xffff0000, v140
    v_lshlrev_b32 v138, 16, v141
    v_and_b32 v139, 0xffff0000, v141
    v_max_f32 v142, v136, v137
    v_max3_f32 v142, v142, v138, v139
    v_mov_b32 v143, v142
    s_nop 1
    v_permlane16_swap_b32 v142, v143
    s_nop 1
    v_max_f32 v142, v142, v143
    v_mov_b32 v143, v142
    s_nop 1
    v_permlane32_swap_b32 v142, v143
    s_nop 1
    v_max_f32 v142, v142, v143
    v_sub_f32 v136, v136, v142
    v_sub_f32 v137, v137, v142
    v_sub_f32 v138, v138, v142
    v_sub_f32 v139, v139, v142
    v_mul_f32 v136, s49, v136
    v_mul_f32 v137, s49, v137
    v_mul_f32 v138, s49, v138
    v_mul_f32 v139, s49, v139
    v_exp_f32 v136, v136
    v_exp_f32 v137, v137
    v_exp_f32 v138, v138
    v_exp_f32 v139, v139
    s_nop 0
    v_add_f32 v142, v136, v137
    v_add_f32 v143, v138, v139
    v_add_f32 v142, v142, v143
    v_mov_b32 v143, v142
    s_nop 1
    v_permlane16_swap_b32 v142, v143
    s_nop 1
    v_add_f32 v142, v142, v143
    v_mov_b32 v143, v142
    s_nop 1
    v_permlane32_swap_b32 v142, v143
    s_nop 1
    v_add_f32 v142, v142, v143
    v_rcp_f32 v142, v142
    s_nop 0
    v_mul_f32 v136, v136, v142
    v_mul_f32 v137, v137, v142
    v_mul_f32 v138, v138, v142
    v_mul_f32 v139, v139, v142
    v_cvt_pk_bf16_f32 v140, v136, v137
    v_cvt_pk_bf16_f32 v141, v138, v139
    ds_write_b64 v144, v[140:141] offset:512
    s_waitcnt lgkmcnt(0)
    v_add_u32 v144, 0x400, v144
    s_add_u32 s42, s42, 0x2000
    s_branch L_hloop
L_hv:
    ds_read_b128 v[8:11], v3 offset:0
    ds_read_b128 v[12:15], v3 offset:1024
    ds_read_b128 v[16:19], v3 offset:2048
    ds_read_b128 v[20:23], v3 offset:3072
    ds_read_b128 v[24:27], v3 offset:4096
    ds_read_b128 v[28:31], v3 offset:5120
    ds_read_b128 v[32:35], v3 offset:6144
    ds_read_b128 v[36:39], v3 offset:7168
    ds_read_b64 v[240:241], v4
    ds_read_b64 v[242:243], v4 offset:512
    s_mov_b32 s42, 0
    s_waitcnt lgkmcnt(0)
    s_branch L_vepi
L_code_end:
.section .rodata,"a"
.p2align 6
.amdhsa_kernel standalone__low_rank_proj_linformer__sampling_kernel
  .amdhsa_next_free_vgpr 256
  .amdhsa_next_free_sgpr 64
  .amdhsa_accum_offset 256
  .amdhsa_group_segment_fixed_size 0
  .amdhsa_kernarg_size 64
  .amdhsa_user_sgpr_count 2
  .amdhsa_user_sgpr_kernarg_segment_ptr 1
  .amdhsa_system_sgpr_workgroup_id_x 1
  .amdhsa_float_denorm_mode_32 3
.end_amdhsa_kernel
```
